```python
import torch

def _softmax(x, axis=-1):
    return torch.softmax(x, dim=axis)
def _gelu(x):
    return torch.nn.functional.gelu(x, approximate="tanh")
def _silu(x):
    return torch.nn.functional.silu(x)
def _sigmoid(x):
    return torch.sigmoid(x)
def _layernorm(x, axis=-1, eps=1e-5):
    m = x.mean(dim=axis, keepdim=True)
    v = x.var(dim=axis, keepdim=True, unbiased=False)
    return (x - m) / torch.sqrt(v + eps)
def _scatter_add(tgt, idx, src, axis=0):
    return tgt.clone().index_add_(axis, idx, src)
def _segment_sum(src, seg, n):
    out = torch.zeros((n,) + src.shape[1:], dtype=src.dtype)
    return out.index_add_(0, seg, src)
def _pad(x, pw):
    flat = tuple(v for pair in reversed(pw) for v in pair)
    return torch.nn.functional.pad(x, flat)

kernel_name = 'parallel_sum__sliding_block_cached__glu_gated_glu__decode'

def setup_inputs():

    _w = (lambda a: (lambda t: t.to(torch.bfloat16) if t.is_floating_point() else t)(torch.as_tensor(a)))
    def _A_setup():
        B, Sq, D = 2, 1, 512
        Hq, Hkv, Sk, Dh = 32, 32, 4096, 128
        assert Hq % Hkv == 0, (Hq, Hkv)
        return {
            "x": _w((lambda *s: torch.randn(*s, dtype=torch.bfloat16) * 0.05)(B, Sq, D)),
            "k_cache": _w((lambda *s: torch.randn(*s, dtype=torch.bfloat16) * 3.2)(B, Hkv, Sk, Dh)),
            "v_cache": _w((lambda *s: torch.randn(*s, dtype=torch.bfloat16) * 1.6)(B, Hkv, Sk, Dh)),
            "wq": _w((lambda *s: torch.randn(*s, dtype=torch.bfloat16) * 3.2)(D, Hq * Dh) * (D ** -0.5)),
            "wo": _w((lambda *s: torch.randn(*s, dtype=torch.bfloat16) * 1.6)(Hq * Dh, D) * ((Hq * Dh) ** -0.5)),
        }
    _A_in = _A_setup()

    def _B_setup():
        B, S, D, F = 2, 1, 512, 1376
        return {
            "x": _w((lambda *s: torch.randn(*s, dtype=torch.bfloat16) * 0.05)(B, S, D)),
            "w_gate": _w((lambda *s: torch.randn(*s, dtype=torch.bfloat16) * 0.2)(D, F)),
            "w_up": _w((lambda *s: torch.randn(*s, dtype=torch.bfloat16) * 0.05)(D, F)),
            "w_down": _w((lambda *s: torch.randn(*s, dtype=torch.bfloat16) * 0.05)(F, D)),
        }
    _B_in = _B_setup()

    return {
        "A_x": _A_in["x"],
        "A_k_cache": _A_in["k_cache"],
        "A_v_cache": _A_in["v_cache"],
        "A_wq": _A_in["wq"],
        "A_wo": _A_in["wo"],
        "B_x": _B_in["x"],
        "B_w_gate": _B_in["w_gate"],
        "B_w_up": _B_in["w_up"],
        "B_w_down": _B_in["w_down"],
    }

def reference(A_x, A_k_cache, A_v_cache, A_wq, A_wo, B_x, B_w_gate, B_w_up, B_w_down):
    def _A_ref(x, k_cache, v_cache, wq, wo):
        B, Sq, D = x.shape
        Hq, Dh = 32, 128
        Hkv, Sk = k_cache.shape[1], k_cache.shape[2]
        W = min(4096, max(256, Sk // 4))
        rep = Hq // Hkv
        q = (lambda x, *d: x.permute(*d))((x @ wq).reshape(B, Sq, Hq, Dh), 0, 2, 1, 3)
        k = (lambda x, n, axis: torch.repeat_interleave(x, n, dim=axis))(k_cache[:, :, Sk - W:, :], rep, axis=1)
        v = (lambda x, n, axis: torch.repeat_interleave(x, n, dim=axis))(v_cache[:, :, Sk - W:, :], rep, axis=1)
        scores = torch.einsum("bhqd,bhkd->bhqk", q, k) * (Dh ** -0.5)
        p = _softmax(scores, axis=-1)
        o = torch.einsum("bhqk,bhkd->bhqd", p, v)
        return (lambda x, *d: x.permute(*d))(o, 0, 2, 1, 3).reshape(B, Sq, Hq * Dh) @ wo

    def _B_ref(x, w_gate, w_up, w_down):
        g = torch.einsum("bsd,df->bsf", x, w_gate)
        u = torch.einsum("bsd,df->bsf", x, w_up)
        h = _sigmoid(g) * u
        return torch.einsum("bsf,fd->bsd", h, w_down)

    x = A_x
    xn = _layernorm(x, axis=-1)
    return x + _A_ref(xn, A_k_cache, A_v_cache, A_wq, A_wo) + _B_ref(xn, B_w_gate, B_w_up, B_w_down)
```

```asm
; @launch grid=(256,1,1) block=(640,1,1) lds=5120
.amdgcn_target "amdgcn-amd-amdhsa--gfx950"
.text
.globl parallel_sum__sliding_block_cached__glu_gated_glu__decode_kernel
.p2align 8
.type parallel_sum__sliding_block_cached__glu_gated_glu__decode_kernel,@function
parallel_sum__sliding_block_cached__glu_gated_glu__decode_kernel:
    s_load_dwordx16 s[4:19], s[0:1], 0
    s_load_dwordx8 s[20:27], s[0:1], 64
    s_cmp_ge_u32 s2, 256
    s_cbranch_scc1 L_end
    v_lshrrev_b32 v1, 6, v0
    v_and_b32 v0, 63, v0
    v_readfirstlane_b32 s3, v1
    s_and_b32 s40, s2, 7
    s_lshr_b32 s41, s2, 3
    s_lshl_b32 s40, s40, 2
    s_lshr_b32 s42, s41, 3
    s_add_u32 s40, s40, s42
    s_and_b32 s41, s41, 7
    s_cmp_lt_u32 s3, 2
    s_cbranch_scc0 L_kvrole
    s_setprio 3
    s_mov_b32 s57, 16
    s_mov_b32 s47, 0x100
    s_and_b32 s96, s2, 7
    s_lshl_b32 s96, s96, 5
    s_lshr_b32 s42, s2, 3
    s_add_u32 s96, s96, s42
    s_mov_b32 s48, 0
    s_mov_b32 s30, 2048
    s_mov_b32 s31, 0x20000
    s_mov_b32 s35, 0x20000
    s_mov_b32 s39, 0x20000
    s_mov_b32 s38, 3145728
    v_lshrrev_b32 v4, 4, v0
    v_and_b32 v5, 15, v0
    v_lshlrev_b32 v100, 5, v0
    v_mov_b32 v124, 0
    v_mov_b32 v125, 0
    v_mov_b32 v126, 0
    v_mov_b32 v127, 0
    s_cmp_eq_u32 s3, 0
    s_cbranch_scc0 L_fsetup
    ds_write_b128 v124, v[124:127] offset:256
    s_movk_i32 s49, 8192
    s_lshl_b32 s54, s41, 6
    s_lshl_b32 s50, s41, 19
    s_lshl_b32 s42, s40, 8
    s_add_u32 s50, s50, s42
    s_lshl_b32 s51, s40, 13
    s_lshl_b32 s42, s41, 10
    s_add_u32 s51, s51, s42
    s_add_u32 s51, s51, 65536
    s_movk_i32 s55, 512
    s_mov_b32 s34, 0x400000
    s_waitcnt lgkmcnt(0)
    s_mov_b32 s32, s10
    s_mov_b32 s33, s11
L_wcommon:
    s_load_dword s52, s[26:27], 0
    s_mov_b32 s28, s4
    s_mov_b32 s29, s5
    s_lshl_b32 s42, s49, 4
    v_mul_lo_u32 v1, v4, s42
    v_cmp_gt_u32 vcc, s57, v5
    v_lshl_add_u32 v1, v5, 4, v1
    v_mov_b32 v101, 0x1000000
    v_cndmask_b32 v1, v101, v1, vcc
    buffer_load_dwordx4 v[104:107], v100, s[28:31], 0 offen
    buffer_load_dwordx4 v[108:111], v100, s[28:31], 0 offen offset:16
    v_lshrrev_b32 v101, 5, v0
    v_and_b32 v102, 31, v0
    v_lshlrev_b32 v101, 10, v101
    v_lshl_add_u32 v101, v102, 2, v101
    s_lshl_b32 s42, s54, 1
    s_and_b32 s42, s42, 0x3fc
    buffer_load_dword v103, v101, s[28:31], s42 offen
    v_and_b32 v101, 1, v4
    v_lshrrev_b32 v100, 1, v4
    v_lshl_add_u32 v100, v101, 1, v100
    s_lshl_b32 s42, s96, 3
    v_lshl_add_u32 v127, v100, 1, s42
L_issue:
    buffer_load_dwordx4 v[16:19], v1, s[32:35], s50 offen nt
    s_add_u32 s50, s50, s49
    buffer_load_dwordx4 v[20:23], v1, s[32:35], s50 offen nt
    s_add_u32 s50, s50, s49
    buffer_load_dwordx4 v[24:27], v1, s[32:35], s50 offen nt
    s_add_u32 s50, s50, s49
    buffer_load_dwordx4 v[28:31], v1, s[32:35], s50 offen nt
    s_add_u32 s50, s50, s49
    buffer_load_dwordx4 v[32:35], v1, s[32:35], s50 offen nt
    s_add_u32 s50, s50, s49
    buffer_load_dwordx4 v[36:39], v1, s[32:35], s50 offen nt
    s_add_u32 s50, s50, s49
    buffer_load_dwordx4 v[40:43], v1, s[32:35], s50 offen nt
    s_add_u32 s50, s50, s49
    buffer_load_dwordx4 v[44:47], v1, s[32:35], s50 offen nt
    s_add_u32 s50, s50, s49
    buffer_load_dwordx4 v[48:51], v1, s[32:35], s50 offen nt
    s_add_u32 s50, s50, s49
    buffer_load_dwordx4 v[52:55], v1, s[32:35], s50 offen nt
    s_add_u32 s50, s50, s49
    buffer_load_dwordx4 v[56:59], v1, s[32:35], s50 offen nt
    s_add_u32 s50, s50, s49
    buffer_load_dwordx4 v[60:63], v1, s[32:35], s50 offen nt
    s_add_u32 s50, s50, s49
    buffer_load_dwordx4 v[64:67], v1, s[32:35], s50 offen nt
    s_add_u32 s50, s50, s49
    buffer_load_dwordx4 v[68:71], v1, s[32:35], s50 offen nt
    s_add_u32 s50, s50, s49
    buffer_load_dwordx4 v[72:75], v1, s[32:35], s50 offen nt
    s_add_u32 s50, s50, s49
    buffer_load_dwordx4 v[76:79], v1, s[32:35], s50 offen nt
    buffer_load_ushort v125, v127, s[28:31], 0 offen
    s_cmp_eq_u32 s48, 1
    s_cbranch_scc1 L_phase1
    s_barrier
    s_mov_b32 s36, s26
    s_mov_b32 s37, s27
    v_mov_b32 v112, v4
    v_mov_b32 v113, v5
    v_and_b32 v2, 1, v0
    v_cmp_eq_u32 vcc, 1, v2
    v_mov_b32 v3, 0x0c0c0100
    v_mov_b32 v4, 0x01000c0c
    v_cndmask_b32 v3, v3, v4, vcc
    v_mov_b32 v4, 0x0c0c0302
    v_mov_b32 v5, 0x03020c0c
    v_cndmask_b32 v4, v4, v5, vcc
    v_bfe_u32 v2, v0, 1, 2
    v_mov_b32 v5, 0x0c0c0c0c
    v_cmp_eq_u32 vcc, 0, v2
    s_nop 1
    v_cndmask_b32 v8, v5, v3, vcc
    v_cndmask_b32 v12, v5, v4, vcc
    v_cmp_eq_u32 vcc, 1, v2
    s_nop 1
    v_cndmask_b32 v9, v5, v3, vcc
    v_cndmask_b32 v13, v5, v4, vcc
    v_cmp_eq_u32 vcc, 2, v2
    s_nop 1
    v_cndmask_b32 v10, v5, v3, vcc
    v_cndmask_b32 v14, v5, v4, vcc
    v_cmp_eq_u32 vcc, 3, v2
    s_nop 1
    v_cndmask_b32 v11, v5, v3, vcc
    v_cndmask_b32 v15, v5, v4, vcc
    v_lshlrev_b32 v122, 10, v0
    v_min_u32 v123, 23, v0
    v_lshlrev_b32 v123, 10, v123
    s_lshr_b32 s42, s96, 7
    s_lshl_b32 s42, s42, 9
    s_and_b32 s43, s96, 31
    s_lshl_b32 s43, s43, 4
    s_add_u32 s42, s42, s43
    s_bfe_u32 s43, s96, 0x20005
    s_mul_i32 s59, s43, 24576
    s_lshl_b32 s58, s43, 16
    s_add_u32 s59, s59, s42
    s_add_u32 s58, s58, s42
    s_add_u32 s58, s58, 917504
    s_add_u32 s59, s59, 1179648
    v_add_u32 v123, s59, v123
    s_lshl_b32 s43, s40, 11
    s_add_u32 s43, s43, 917504
    v_bfe_u32 v114, v0, 1, 2
    v_and_b32 v115, 1, v0
    v_lshlrev_b32 v114, 16, v114
    v_lshl_add_u32 v114, v115, 10, v114
    v_add_u32 v114, s43, v114
    v_cmp_gt_u32 vcc, 24, v0
    s_nop 1
    v_cndmask_b32 v123, v114, v123, vcc
    v_cndmask_b32 v132, 0, -1, vcc
    s_mov_b32 s59, 0
    s_mov_b32 s60, s22
    s_mov_b32 s61, s23
    s_mov_b32 s62, 2048
    s_mov_b32 s63, 0x20000
    v_mov_b32 v7, 0xff
    s_lshl_b32 s42, s3, 8
    v_lshlrev_b32 v3, 2, v0
    v_add_u32 v3, s42, v3
    v_lshrrev_b32 v6, 3, v113
    v_lshlrev_b32 v6, 7, v6
    v_lshl_add_u32 v6, v112, 5, v6
    v_add_u32 v6, s42, v6
    v_lshrrev_b32 v4, 1, v112
    v_mul_lo_u32 v2, v4, s55
    v_lshl_add_u32 v2, v113, 5, v2
    v_and_b32 v4, 16, v0
    v_add_u32 v2, v2, v4
    s_mov_b32 s45, 0xffff0000
    s_mov_b32 s46, 0x3fb8aa3b
    s_waitcnt lgkmcnt(0)
    s_add_u32 s56, s52, 1
    s_addc_u32 s56, s56, 0
    s_and_b32 s52, s56, 0xff
    s_lshr_b32 s98, s56, 8
    s_lshr_b32 s99, s56, 16
    s_lshr_b32 s100, s56, 24
    s_add_u32 s98, s98, s52
    s_add_u32 s99, s99, s52
    s_add_u32 s100, s100, s52
    s_cmp_eq_u32 s48, 2
    s_cbranch_scc1 L_fphase1
    v_mov_b32 v114, 0x3f803f80
    v_mov_b32 v115, 0
    s_waitcnt vmcnt(18)
    v_dot2c_f32_bf16 v115, v104, v114
    v_dot2c_f32_bf16 v115, v105, v114
    v_dot2c_f32_bf16 v115, v106, v114
    v_dot2c_f32_bf16 v115, v107, v114
    v_dot2c_f32_bf16 v115, v108, v114
    v_dot2c_f32_bf16 v115, v109, v114
    v_dot2c_f32_bf16 v115, v110, v114
    v_dot2c_f32_bf16 v115, v111, v114
    s_nop 2
    v_add_f32_dpp v115, v115, v115 row_ror:8 row_mask:0xf bank_mask:0xf
    s_nop 1
    v_add_f32_dpp v115, v115, v115 row_ror:4 row_mask:0xf bank_mask:0xf
    s_nop 1
    v_add_f32_dpp v115, v115, v115 row_ror:2 row_mask:0xf bank_mask:0xf
    s_nop 1
    v_add_f32_dpp v115, v115, v115 row_ror:1 row_mask:0xf bank_mask:0xf
    v_mov_b32 v116, v115
    s_nop 1
    v_permlane16_swap_b32 v115, v116
    v_add_f32 v115, v115, v116
    v_mul_f32 v115, 0x3b000000, v115
    v_mov_b32 v117, 0
    v_mov_b32 v120, 0
    v_lshlrev_b32 v118, 16, v104
    v_and_b32 v119, s45, v104
    v_sub_f32 v118, v118, v115
    v_sub_f32 v119, v119, v115
    v_fmac_f32 v117, v118, v118
    v_fmac_f32 v120, v119, v119
    v_lshlrev_b32 v118, 16, v105
    v_and_b32 v119, s45, v105
    v_sub_f32 v118, v118, v115
    v_sub_f32 v119, v119, v115
    v_fmac_f32 v117, v118, v118
    v_fmac_f32 v120, v119, v119
    v_lshlrev_b32 v118, 16, v106
    v_and_b32 v119, s45, v106
    v_sub_f32 v118, v118, v115
    v_sub_f32 v119, v119, v115
    v_fmac_f32 v117, v118, v118
    v_fmac_f32 v120, v119, v119
    v_lshlrev_b32 v118, 16, v107
    v_and_b32 v119, s45, v107
    v_sub_f32 v118, v118, v115
    v_sub_f32 v119, v119, v115
    v_fmac_f32 v117, v118, v118
    v_fmac_f32 v120, v119, v119
    v_lshlrev_b32 v118, 16, v108
    v_and_b32 v119, s45, v108
    v_sub_f32 v118, v118, v115
    v_sub_f32 v119, v119, v115
    v_fmac_f32 v117, v118, v118
    v_fmac_f32 v120, v119, v119
    v_lshlrev_b32 v118, 16, v109
    v_and_b32 v119, s45, v109
    v_sub_f32 v118, v118, v115
    v_sub_f32 v119, v119, v115
    v_fmac_f32 v117, v118, v118
    v_fmac_f32 v120, v119, v119
    v_lshlrev_b32 v118, 16, v110
    v_and_b32 v119, s45, v110
    v_sub_f32 v118, v118, v115
    v_sub_f32 v119, v119, v115
    v_fmac_f32 v117, v118, v118
    v_fmac_f32 v120, v119, v119
    v_lshlrev_b32 v118, 16, v111
    v_and_b32 v119, s45, v111
    v_sub_f32 v118, v118, v115
    v_sub_f32 v119, v119, v115
    v_fmac_f32 v117, v118, v118
    v_fmac_f32 v120, v119, v119
    v_add_f32 v117, v117, v120
    s_nop 1
    v_add_f32_dpp v117, v117, v117 row_ror:8 row_mask:0xf bank_mask:0xf
    s_nop 1
    v_add_f32_dpp v117, v117, v117 row_ror:4 row_mask:0xf bank_mask:0xf
    s_nop 1
    v_add_f32_dpp v117, v117, v117 row_ror:2 row_mask:0xf bank_mask:0xf
    s_nop 1
    v_add_f32_dpp v117, v117, v117 row_ror:1 row_mask:0xf bank_mask:0xf
    v_mov_b32 v116, v117
    s_nop 1
    v_permlane16_swap_b32 v117, v116
    v_add_f32 v117, v117, v116
    v_mul_f32 v117, 0x3b000000, v117
    v_cvt_pk_bf16_f32 v116, v115, v117
    v_lshlrev_b32 v115, 16, v116
    v_and_b32 v117, s45, v116
    v_add_f32 v117, 0x3727c5ac, v117
    v_cvt_pk_bf16_f32 v117, v117, v117
    v_and_b32 v117, s45, v117
    v_sqrt_f32 v117, v117
    s_nop 0
    v_cvt_pk_bf16_f32 v117, v117, v117
    v_and_b32 v117, s45, v117
    v_rcp_f32 v116, v117
    s_waitcnt vmcnt(17)
    v_lshlrev_b32 v118, 16, v103
    v_and_b32 v119, s45, v103
    v_sub_f32 v118, v118, v115
    v_sub_f32 v119, v119, v115
    v_cvt_pk_bf16_f32 v118, v118, v119
    v_and_b32 v119, s45, v118
    v_lshlrev_b32 v118, 16, v118
    v_mul_f32 v120, v118, v116
    v_mul_f32 v121, v119, v116
    v_fma_f32 v118, -v120, v117, v118
    v_fma_f32 v119, -v121, v117, v119
    v_fmac_f32 v120, v118, v116
    v_fmac_f32 v121, v119, v116
    v_cvt_pk_bf16_f32 v120, v120, v121
L_core:
    ds_write_b32 v3, v120 offset:384
    ds_read_b128 v[80:83], v6 offset:384
    ds_read_b128 v[84:87], v6 offset:400
    v_mov_b32 v96, 0
    v_mov_b32 v97, 0
    v_mov_b32 v98, 0
    v_mov_b32 v99, 0
    s_waitcnt lgkmcnt(1)
    v_perm_b32 v88, v80, v80, v8
    v_perm_b32 v89, v80, v80, v9
    v_perm_b32 v90, v80, v80, v10
    v_perm_b32 v91, v80, v80, v11
    v_perm_b32 v92, v80, v80, v12
    v_perm_b32 v93, v80, v80, v13
    v_perm_b32 v94, v80, v80, v14
    v_perm_b32 v95, v80, v80, v15
    s_waitcnt vmcnt(16)
    v_mfma_f32_16x16x32_bf16 v[96:99], v[88:91], v[16:19], v[96:99]
    v_perm_b32 v88, v81, v81, v8
    v_perm_b32 v89, v81, v81, v9
    v_perm_b32 v90, v81, v81, v10
    v_perm_b32 v91, v81, v81, v11
    s_waitcnt vmcnt(15)
    v_mfma_f32_16x16x32_bf16 v[96:99], v[92:95], v[20:23], v[96:99]
    v_perm_b32 v92, v81, v81, v12
    v_perm_b32 v93, v81, v81, v13
    v_perm_b32 v94, v81, v81, v14
    v_perm_b32 v95, v81, v81, v15
    s_waitcnt vmcnt(14)
    v_mfma_f32_16x16x32_bf16 v[96:99], v[88:91], v[24:27], v[96:99]
    v_perm_b32 v88, v82, v82, v8
    v_perm_b32 v89, v82, v82, v9
    v_perm_b32 v90, v82, v82, v10
    v_perm_b32 v91, v82, v82, v11
    s_waitcnt vmcnt(13)
    v_mfma_f32_16x16x32_bf16 v[96:99], v[92:95], v[28:31], v[96:99]
    v_perm_b32 v92, v82, v82, v12
    v_perm_b32 v93, v82, v82, v13
    v_perm_b32 v94, v82, v82, v14
    v_perm_b32 v95, v82, v82, v15
    s_waitcnt vmcnt(12)
    v_mfma_f32_16x16x32_bf16 v[96:99], v[88:91], v[32:35], v[96:99]
    v_perm_b32 v88, v83, v83, v8
    v_perm_b32 v89, v83, v83, v9
    v_perm_b32 v90, v83, v83, v10
    v_perm_b32 v91, v83, v83, v11
    s_waitcnt vmcnt(11)
    v_mfma_f32_16x16x32_bf16 v[96:99], v[92:95], v[36:39], v[96:99]
    v_perm_b32 v92, v83, v83, v12
    v_perm_b32 v93, v83, v83, v13
    v_perm_b32 v94, v83, v83, v14
    v_perm_b32 v95, v83, v83, v15
    s_waitcnt vmcnt(10)
    v_mfma_f32_16x16x32_bf16 v[96:99], v[88:91], v[40:43], v[96:99]
    s_waitcnt lgkmcnt(0)
    v_perm_b32 v88, v84, v84, v8
    v_perm_b32 v89, v84, v84, v9
    v_perm_b32 v90, v84, v84, v10
    v_perm_b32 v91, v84, v84, v11
    s_waitcnt vmcnt(9)
    v_mfma_f32_16x16x32_bf16 v[96:99], v[92:95], v[44:47], v[96:99]
    v_perm_b32 v92, v84, v84, v12
    v_perm_b32 v93, v84, v84, v13
    v_perm_b32 v94, v84, v84, v14
    v_perm_b32 v95, v84, v84, v15
    s_waitcnt vmcnt(8)
    v_mfma_f32_16x16x32_bf16 v[96:99], v[88:91], v[48:51], v[96:99]
    v_perm_b32 v88, v85, v85, v8
    v_perm_b32 v89, v85, v85, v9
    v_perm_b32 v90, v85, v85, v10
    v_perm_b32 v91, v85, v85, v11
    s_waitcnt vmcnt(7)
    v_mfma_f32_16x16x32_bf16 v[96:99], v[92:95], v[52:55], v[96:99]
    v_perm_b32 v92, v85, v85, v12
    v_perm_b32 v93, v85, v85, v13
    v_perm_b32 v94, v85, v85, v14
    v_perm_b32 v95, v85, v85, v15
    s_waitcnt vmcnt(6)
    v_mfma_f32_16x16x32_bf16 v[96:99], v[88:91], v[56:59], v[96:99]
    v_perm_b32 v88, v86, v86, v8
    v_perm_b32 v89, v86, v86, v9
    v_perm_b32 v90, v86, v86, v10
    v_perm_b32 v91, v86, v86, v11
    s_waitcnt vmcnt(5)
    v_mfma_f32_16x16x32_bf16 v[96:99], v[92:95], v[60:63], v[96:99]
    v_perm_b32 v92, v86, v86, v12
    v_perm_b32 v93, v86, v86, v13
    v_perm_b32 v94, v86, v86, v14
    v_perm_b32 v95, v86, v86, v15
    s_waitcnt vmcnt(4)
    v_mfma_f32_16x16x32_bf16 v[96:99], v[88:91], v[64:67], v[96:99]
    v_perm_b32 v88, v87, v87, v8
    v_perm_b32 v89, v87, v87, v9
    v_perm_b32 v90, v87, v87, v10
    v_perm_b32 v91, v87, v87, v11
    s_waitcnt vmcnt(3)
    v_mfma_f32_16x16x32_bf16 v[96:99], v[92:95], v[68:71], v[96:99]
    v_perm_b32 v92, v87, v87, v12
    v_perm_b32 v93, v87, v87, v13
    v_perm_b32 v94, v87, v87, v14
    v_perm_b32 v95, v87, v87, v15
    s_waitcnt vmcnt(2)
    v_mfma_f32_16x16x32_bf16 v[96:99], v[88:91], v[72:75], v[96:99]
    s_waitcnt vmcnt(1)
    v_mfma_f32_16x16x32_bf16 v[96:99], v[92:95], v[76:79], v[96:99]
L_corepost:
    s_or_b32 s42, s48, s3
    s_nop 6
    v_bfi_b32 v96, v7, s52, v96
    v_bfi_b32 v97, v7, s98, v97
    v_bfi_b32 v98, v7, s99, v98
    v_bfi_b32 v99, v7, s100, v99
    s_cbranch_scc0 L_qpost0
    buffer_store_dwordx4 v[96:99], v2, s[36:39], s51 offen sc1
    s_cmp_eq_u32 s3, 0
    s_cbranch_scc0 L_fpost
L_ystored:
    s_mov_b32 s53, 262143
    s_mov_b32 s44, 65
    s_waitcnt vmcnt(0)
L_ypoll:
    buffer_load_dwordx4 v[112:115], v122, s[36:39], s58 offen sc1
    buffer_load_dwordx4 v[116:119], v123, s[36:39], s59 offen sc1
    s_waitcnt vmcnt(0)
    v_xor_b32 v126, s52, v112
    v_bitop3_b32 v126, v113, s98, v126 bitop3:0xbe
    v_bitop3_b32 v126, v114, s99, v126 bitop3:0xbe
    v_bitop3_b32 v126, v115, s100, v126 bitop3:0xbe
    v_bitop3_b32 v126, v116, s52, v126 bitop3:0xbe
    v_bitop3_b32 v126, v117, s98, v126 bitop3:0xbe
    v_bitop3_b32 v126, v118, s99, v126 bitop3:0xbe
    v_bitop3_b32 v126, v119, s100, v126 bitop3:0xbe
    v_and_b32 v126, v7, v126
    v_cmp_ne_u32 vcc, 0, v126
    s_cbranch_vccz L_ypoll_done
    s_bcnt1_i32_b64 s44, vcc
    s_and_b32 s43, s53, 127
    s_cbranch_scc1 L_ynob
    s_mov_b64 exec, -1
    buffer_store_dwordx4 v[128:131], v102, s[36:39], s47 offen sc1
    s_waitcnt vmcnt(0)
L_ynob:
    s_mov_b64 exec, vcc
    s_sub_u32 s53, s53, 1
    s_cbranch_scc0 L_ypoll
L_ypoll_done:
    s_mov_b64 exec, -1
    v_cmp_gt_u32 vcc, 24, v0
    v_permlane32_swap_b32 v112, v113
    v_permlane32_swap_b32 v114, v115
    v_cndmask_b32 v108, 0, v116, vcc
    v_cndmask_b32 v109, 0, v117, vcc
    v_cndmask_b32 v110, 0, v118, vcc
    v_cndmask_b32 v111, 0, v119, vcc
    v_add_f32 v112, v112, v113
    v_add_f32 v114, v114, v115
    v_permlane32_swap_b32 v108, v109
    v_permlane32_swap_b32 v110, v111
    v_permlane16_swap_b32 v112, v114
    v_add_f32 v108, v108, v109
    v_add_f32 v110, v110, v111
    v_add_f32 v112, v112, v114
    s_mov_b32 s42, 0x00010001
    v_permlane16_swap_b32 v108, v110
    v_lshlrev_b32 v125, 16, v125
    v_add_f32 v108, v108, v110
    v_add_f32_dpp v112, v112, v112 row_ror:8 row_mask:0xf bank_mask:0xf
    s_nop 0
    v_add_f32_dpp v108, v108, v108 row_ror:8 row_mask:0xf bank_mask:0xf
    v_add_f32_dpp v112, v112, v112 row_ror:4 row_mask:0xf bank_mask:0xf
    s_nop 0
    v_add_f32_dpp v108, v108, v108 row_ror:4 row_mask:0xf bank_mask:0xf
    v_add_f32_dpp v112, v112, v112 row_ror:2 row_mask:0xf bank_mask:0xf
    s_nop 0
    v_add_f32_dpp v108, v108, v108 row_ror:2 row_mask:0xf bank_mask:0xf
    v_add_f32_dpp v112, v112, v112 row_ror:1 row_mask:0xf bank_mask:0xf
    s_nop 0
    v_add_f32_dpp v108, v108, v108 row_ror:1 row_mask:0xf bank_mask:0xf
    v_cvt_pk_bf16_f32 v112, v112, v108
    v_and_b32 v108, s45, v112
    v_lshlrev_b32 v112, 16, v112
    v_add_f32 v112, v125, v112
    v_cvt_pk_bf16_f32 v112, v112, v112
    v_and_b32 v112, s45, v112
    v_add_f32 v112, v112, v108
    v_cvt_pk_bf16_f32 v112, v112, v112
    s_mov_b32 exec_lo, s42
    s_mov_b32 exec_hi, s42
    buffer_store_short v112, v127, s[60:63], 0 offen
    s_cmp_eq_u32 s2, 0
    s_cbranch_scc0 L_noeps
    v_mov_b32 v100, 0
    v_mov_b32 v101, s56
    buffer_store_dword v101, v100, s[36:39], 0 offen sc1
L_noeps:
L_end:
    s_endpgm
L_qpost0:
    buffer_store_dwordx4 v[96:99], v2, s[36:39], s51 offen
    s_add_u32 s51, s51, 2097152
    v_lshrrev_b32 v100, 5, v0
    v_and_b32 v101, 31, v0
    v_lshlrev_b32 v102, 10, v100
    v_lshl_add_u32 v102, v101, 4, v102
    v_add_u32 v103, 4096, v102
    s_lshl_b32 s42, s40, 13
    s_lshr_b32 s43, s41, 2
    s_lshl_b32 s43, s43, 9
    s_add_u32 s42, s42, s43
    s_add_u32 s42, s42, 65536
    s_mov_b32 s53, 262143
L_qpoll:
    s_mov_b32 s57, s42
    s_and_b32 s44, s53, 127
    s_cbranch_scc1 L_qpoll_a
    buffer_store_dwordx4 v[96:99], v2, s[36:39], s51 offen sc1
    s_add_u32 s57, s57, 2097152
L_qpoll_a:
    buffer_load_dwordx4 v[104:107], v102, s[36:39], s57 offen sc1
    buffer_load_dwordx4 v[108:111], v102, s[36:39], s57 offen offset:2048 sc1
    buffer_load_dwordx4 v[112:115], v103, s[36:39], s57 offen sc1
    buffer_load_dwordx4 v[116:119], v103, s[36:39], s57 offen offset:2048 sc1
    s_waitcnt vmcnt(0)
    v_xor_b32 v126, s52, v104
    v_bitop3_b32 v126, v105, s98, v126 bitop3:0xbe
    v_bitop3_b32 v126, v106, s99, v126 bitop3:0xbe
    v_bitop3_b32 v126, v107, s100, v126 bitop3:0xbe
    v_bitop3_b32 v126, v108, s52, v126 bitop3:0xbe
    v_bitop3_b32 v126, v109, s98, v126 bitop3:0xbe
    v_bitop3_b32 v126, v110, s99, v126 bitop3:0xbe
    v_bitop3_b32 v126, v111, s100, v126 bitop3:0xbe
    v_bitop3_b32 v126, v112, s52, v126 bitop3:0xbe
    v_bitop3_b32 v126, v113, s98, v126 bitop3:0xbe
    v_bitop3_b32 v126, v114, s99, v126 bitop3:0xbe
    v_bitop3_b32 v126, v115, s100, v126 bitop3:0xbe
    v_bitop3_b32 v126, v116, s52, v126 bitop3:0xbe
    v_bitop3_b32 v126, v117, s98, v126 bitop3:0xbe
    v_bitop3_b32 v126, v118, s99, v126 bitop3:0xbe
    v_bitop3_b32 v126, v119, s100, v126 bitop3:0xbe
    v_and_b32 v126, v7, v126
    v_cmp_ne_u32 vcc, 0, v126
    s_cbranch_vccz L_qpoll_done
    s_sub_u32 s53, s53, 1
    s_cbranch_scc0 L_qpoll
L_qpoll_done:
    v_pk_add_f32 v[104:105], v[104:105], v[108:109]
    v_pk_add_f32 v[106:107], v[106:107], v[110:111]
    v_pk_add_f32 v[112:113], v[112:113], v[116:117]
    v_pk_add_f32 v[114:115], v[114:115], v[118:119]
    v_pk_add_f32 v[104:105], v[104:105], v[112:113]
    v_pk_add_f32 v[106:107], v[106:107], v[114:115]
    v_lshlrev_b32 v101, 3, v101
    v_lshl_add_u32 v101, v100, 2, v101
    v_permlane32_swap_b32 v104, v106
    v_permlane32_swap_b32 v105, v107
    v_mov_b32 v100, 1
    v_add_f32 v104, v104, v106
    v_add_f32 v105, v105, v107
    v_cvt_pk_bf16_f32 v104, v104, v105
    ds_write_b32 v101, v104 offset:0
    ds_write_b32 v124, v100 offset:256
    s_mov_b32 s97, s51
    s_lshl_b32 s50, s40, 17
    s_and_b32 s42, s41, 1
    s_lshl_b32 s43, s42, 16
    s_add_u32 s50, s50, s43
    s_lshr_b32 s43, s41, 1
    s_lshl_b32 s44, s43, 8
    s_add_u32 s50, s50, s44
    s_lshl_b32 s51, s43, 16
    s_lshl_b32 s44, s40, 11
    s_add_u32 s51, s51, s44
    s_lshl_b32 s44, s42, 10
    s_add_u32 s51, s51, s44
    s_add_u32 s51, s51, 917504
    s_mov_b32 s32, s12
    s_mov_b32 s33, s13
    s_mov_b32 s53, 2097152
L_ispin:
    ds_read_b32 v100, v124 offset:260
    s_waitcnt lgkmcnt(0)
    v_readfirstlane_b32 s57, v100
    s_sub_u32 s53, s53, 1
    s_cbranch_scc1 L_ispin_done
    s_cmp_lg_u32 s57, 8
    s_cbranch_scc1 L_ispin
L_ispin_done:
L_toph1:
    s_mov_b32 s48, 1
    s_movk_i32 s49, 1024
    v_lshrrev_b32 v4, 4, v0
    v_and_b32 v5, 15, v0
    v_lshlrev_b32 v1, 14, v4
    v_lshl_add_u32 v1, v5, 4, v1
    v_lshrrev_b32 v4, 1, v4
    v_lshlrev_b32 v2, 9, v4
    v_lshl_add_u32 v2, v5, 5, v2
    v_and_b32 v4, 16, v0
    v_add_u32 v2, v2, v4
    s_branch L_issue
L_phase1:
    s_cmp_eq_u32 s3, 0
    s_cbranch_scc0 L_fphase1
    v_lshlrev_b32 v101, 3, v0
    v_lshlrev_b32 v102, 4, v0
    s_lshl_b32 s42, s40, 13
    s_lshl_b32 s43, s41, 10
    s_add_u32 s42, s42, 655360
    s_add_u32 s43, s43, s42
    s_add_u32 s47, s43, 2097152
    s_and_b32 s44, s41, 1
    s_lshl_b32 s44, s44, 9
    s_add_u32 s42, s42, s44
    v_lshrrev_b32 v103, 5, v0
    v_and_b32 v121, 31, v0
    v_lshlrev_b32 v103, 12, v103
    v_lshl_add_u32 v103, v121, 4, v103
    s_mov_b32 s53, 2097152
L_mspin:
    ds_read_b32 v100, v124 offset:264
    ds_read_b128 v[80:83], v124 offset:288
    ds_read_b128 v[84:87], v124 offset:304
    ds_read_b128 v[88:91], v124 offset:320
    ds_read_b128 v[92:95], v124 offset:336
    s_waitcnt lgkmcnt(0)
    v_readfirstlane_b32 s57, v100
    s_sub_u32 s53, s53, 1
    s_cbranch_scc1 L_mspin_done
    s_cmp_lg_u32 s57, 8
    s_cbranch_scc1 L_mspin
L_mspin_done:
    v_max3_f32 v130, v80, v81, v82
    v_max3_f32 v131, v83, v84, v85
    v_max3_f32 v130, v130, v86, v87
    v_max_f32 v130, v130, v131
    v_sub_f32 v80, v80, v130
    v_sub_f32 v81, v81, v130
    v_sub_f32 v82, v82, v130
    v_sub_f32 v83, v83, v130
    v_sub_f32 v84, v84, v130
    v_sub_f32 v85, v85, v130
    v_sub_f32 v86, v86, v130
    v_sub_f32 v87, v87, v130
    v_mul_f32 v80, s46, v80
    v_mul_f32 v81, s46, v81
    v_mul_f32 v82, s46, v82
    v_mul_f32 v83, s46, v83
    v_mul_f32 v84, s46, v84
    v_mul_f32 v85, s46, v85
    v_mul_f32 v86, s46, v86
    v_mul_f32 v87, s46, v87
    v_exp_f32 v80, v80
    v_exp_f32 v81, v81
    v_exp_f32 v82, v82
    v_exp_f32 v83, v83
    v_exp_f32 v84, v84
    v_exp_f32 v85, v85
    v_exp_f32 v86, v86
    v_exp_f32 v87, v87
    v_mul_f32 v131, v80, v88
    v_fmac_f32 v131, v81, v89
    v_fmac_f32 v131, v82, v90
    v_fmac_f32 v131, v83, v91
    v_fmac_f32 v131, v84, v92
    v_fmac_f32 v131, v85, v93
    v_fmac_f32 v131, v86, v94
    v_fmac_f32 v131, v87, v95
    v_bfi_b32 v130, v7, s99, v130
    v_bfi_b32 v131, v7, s100, v131
    s_mov_b32 s53, 2097152
L_ospin:
    ds_read_b32 v100, v124 offset:268
    ds_read_b64 v[104:105], v101 offset:1024
    ds_read_b64 v[106:107], v101 offset:1536
    ds_read_b64 v[108:109], v101 offset:2048
    ds_read_b64 v[110:111], v101 offset:2560
    ds_read_b64 v[112:113], v101 offset:3072
    ds_read_b64 v[114:115], v101 offset:3584
    ds_read_b64 v[116:117], v101 offset:4096
    ds_read_b64 v[118:119], v101 offset:4608
    s_waitcnt lgkmcnt(0)
    v_readfirstlane_b32 s57, v100
    s_sub_u32 s53, s53, 1
    s_cbranch_scc1 L_ospin_done
    s_cmp_lg_u32 s57, 8
    s_cbranch_scc1 L_ospin
L_ospin_done:
    v_pk_mul_f32 v[128:129], v[104:105], v[80:81] op_sel_hi:[1,0]
    v_pk_mul_f32 v[88:89], v[106:107], v[80:81] op_sel:[0,1]
    v_pk_fma_f32 v[128:129], v[108:109], v[82:83], v[128:129] op_sel_hi:[1,0,1]
    v_pk_fma_f32 v[88:89], v[110:111], v[82:83], v[88:89] op_sel:[0,1,0]
    v_pk_fma_f32 v[128:129], v[112:113], v[84:85], v[128:129] op_sel_hi:[1,0,1]
    v_pk_fma_f32 v[88:89], v[114:115], v[84:85], v[88:89] op_sel:[0,1,0]
    v_pk_fma_f32 v[128:129], v[116:117], v[86:87], v[128:129] op_sel_hi:[1,0,1]
    v_pk_fma_f32 v[88:89], v[118:119], v[86:87], v[88:89] op_sel:[0,1,0]
    v_pk_add_f32 v[128:129], v[128:129], v[88:89]
    v_bfi_b32 v128, v7, s52, v128
    v_bfi_b32 v129, v7, s98, v129
    buffer_store_dwordx4 v[128:131], v102, s[36:39], s43 offen
    s_mov_b32 s53, 262143
    buffer_load_dwordx4 v[104:107], v103, s[36:39], s42 offen offset:0 sc1
    buffer_load_dwordx4 v[108:111], v103, s[36:39], s42 offen offset:1024 sc1
    buffer_load_dwordx4 v[112:115], v103, s[36:39], s42 offen offset:2048 sc1
    buffer_load_dwordx4 v[116:119], v103, s[36:39], s42 offen offset:3072 sc1
L_oskip:
    s_mov_b32 s49, 0x05040100
    s_mov_b32 s55, 0x07060302
    s_waitcnt vmcnt(19)
    v_perm_b32 v80, v20, v16, s49
    v_perm_b32 v84, v20, v16, s55
    v_perm_b32 v88, v21, v17, s49
    v_perm_b32 v92, v21, v17, s55
    v_perm_b32 v8, v22, v18, s49
    v_perm_b32 v12, v22, v18, s55
    v_perm_b32 v136, v23, v19, s49
    v_perm_b32 v140, v23, v19, s55
    s_waitcnt vmcnt(17)
    v_perm_b32 v81, v28, v24, s49
    v_perm_b32 v85, v28, v24, s55
    v_perm_b32 v89, v29, v25, s49
    v_perm_b32 v93, v29, v25, s55
    v_perm_b32 v9, v30, v26, s49
    v_perm_b32 v13, v30, v26, s55
    v_perm_b32 v137, v31, v27, s49
    v_perm_b32 v141, v31, v27, s55
    s_waitcnt vmcnt(15)
    v_perm_b32 v82, v36, v32, s49
    v_perm_b32 v86, v36, v32, s55
    v_perm_b32 v90, v37, v33, s49
    v_perm_b32 v94, v37, v33, s55
    v_perm_b32 v10, v38, v34, s49
    v_perm_b32 v14, v38, v34, s55
    v_perm_b32 v138, v39, v35, s49
    v_perm_b32 v142, v39, v35, s55
    s_waitcnt vmcnt(13)
    v_perm_b32 v83, v44, v40, s49
    v_perm_b32 v87, v44, v40, s55
    v_perm_b32 v91, v45, v41, s49
    v_perm_b32 v95, v45, v41, s55
    v_perm_b32 v11, v46, v42, s49
    v_perm_b32 v15, v46, v42, s55
    v_perm_b32 v139, v47, v43, s49
    v_perm_b32 v143, v47, v43, s55
    s_waitcnt vmcnt(11)
    v_perm_b32 v16, v52, v48, s49
    v_perm_b32 v20, v52, v48, s55
    v_perm_b32 v24, v53, v49, s49
    v_perm_b32 v28, v53, v49, s55
    v_perm_b32 v32, v54, v50, s49
    v_perm_b32 v36, v54, v50, s55
    v_perm_b32 v40, v55, v51, s49
    v_perm_b32 v44, v55, v51, s55
    s_waitcnt vmcnt(9)
    v_perm_b32 v17, v60, v56, s49
    v_perm_b32 v21, v60, v56, s55
    v_perm_b32 v25, v61, v57, s49
    v_perm_b32 v29, v61, v57, s55
    v_perm_b32 v33, v62, v58, s49
    v_perm_b32 v37, v62, v58, s55
    v_perm_b32 v41, v63, v59, s49
    v_perm_b32 v45, v63, v59, s55
    s_waitcnt vmcnt(7)
    v_perm_b32 v18, v68, v64, s49
    v_perm_b32 v22, v68, v64, s55
    v_perm_b32 v26, v69, v65, s49
    v_perm_b32 v30, v69, v65, s55
    v_perm_b32 v34, v70, v66, s49
    v_perm_b32 v38, v70, v66, s55
    v_perm_b32 v42, v71, v67, s49
    v_perm_b32 v46, v71, v67, s55
    s_waitcnt vmcnt(5)
    v_perm_b32 v19, v76, v72, s49
    v_perm_b32 v23, v76, v72, s55
    v_perm_b32 v27, v77, v73, s49
    v_perm_b32 v31, v77, v73, s55
    v_perm_b32 v35, v78, v74, s49
    v_perm_b32 v39, v78, v74, s55
    v_perm_b32 v43, v79, v75, s49
    v_perm_b32 v47, v79, v75, s55
    s_branch L_opoll_w
L_opoll:
    s_mov_b32 s57, s42
    s_and_b32 s44, s53, 127
    s_cbranch_scc1 L_opoll_a
    buffer_store_dwordx4 v[128:131], v102, s[36:39], s47 offen sc1
    buffer_store_dwordx4 v[96:99], v2, s[36:39], s97 offen sc1
    s_add_u32 s57, s57, 2097152
L_opoll_a:
    buffer_load_dwordx4 v[104:107], v103, s[36:39], s57 offen sc1
    buffer_load_dwordx4 v[108:111], v103, s[36:39], s57 offen offset:1024 sc1
    buffer_load_dwordx4 v[112:115], v103, s[36:39], s57 offen offset:2048 sc1
    buffer_load_dwordx4 v[116:119], v103, s[36:39], s57 offen offset:3072 sc1
L_opoll_w:
    s_waitcnt vmcnt(0)
    v_xor_b32 v126, s52, v104
    v_bitop3_b32 v126, v105, s98, v126 bitop3:0xbe
    v_bitop3_b32 v126, v106, s99, v126 bitop3:0xbe
    v_bitop3_b32 v126, v107, s100, v126 bitop3:0xbe
    v_bitop3_b32 v126, v108, s52, v126 bitop3:0xbe
    v_bitop3_b32 v126, v109, s98, v126 bitop3:0xbe
    v_bitop3_b32 v126, v110, s99, v126 bitop3:0xbe
    v_bitop3_b32 v126, v111, s100, v126 bitop3:0xbe
    v_bitop3_b32 v126, v112, s52, v126 bitop3:0xbe
    v_bitop3_b32 v126, v113, s98, v126 bitop3:0xbe
    v_bitop3_b32 v126, v114, s99, v126 bitop3:0xbe
    v_bitop3_b32 v126, v115, s100, v126 bitop3:0xbe
    v_bitop3_b32 v126, v116, s52, v126 bitop3:0xbe
    v_bitop3_b32 v126, v117, s98, v126 bitop3:0xbe
    v_bitop3_b32 v126, v118, s99, v126 bitop3:0xbe
    v_bitop3_b32 v126, v119, s100, v126 bitop3:0xbe
    v_and_b32 v126, v7, v126
    v_cmp_ne_u32 vcc, 0, v126
    s_cbranch_vccz L_opoll_done
    s_sub_u32 s53, s53, 1
    s_cbranch_scc0 L_opoll
L_opoll_done:
    v_and_b32 v106, s45, v106
    v_and_b32 v110, s45, v110
    v_and_b32 v114, s45, v114
    v_and_b32 v118, s45, v118
    v_max3_f32 v120, v106, v110, v114
    v_max_f32 v120, v120, v118
    v_sub_f32 v106, v106, v120
    v_sub_f32 v110, v110, v120
    v_sub_f32 v114, v114, v120
    v_sub_f32 v118, v118, v120
    v_mul_f32 v106, s46, v106
    v_mul_f32 v110, s46, v110
    v_mul_f32 v114, s46, v114
    v_mul_f32 v118, s46, v118
    v_exp_f32 v106, v106
    v_exp_f32 v110, v110
    v_exp_f32 v114, v114
    v_exp_f32 v118, v118
    v_mul_f32 v107, v107, v106
    v_mul_f32 v104, v104, v106
    v_fmac_f32 v107, v111, v110
    v_mul_f32 v105, v105, v106
    v_fmac_f32 v107, v115, v114
    v_fmac_f32 v104, v108, v110
    v_fmac_f32 v107, v119, v118
    v_fmac_f32 v105, v109, v110
    v_rcp_f32 v107, v107
    v_fmac_f32 v104, v112, v114
    v_fmac_f32 v105, v113, v114
    v_fmac_f32 v104, v116, v118
    v_fmac_f32 v105, v117, v118
    v_mul_f32 v104, v104, v107
    v_mul_f32 v105, v105, v107
    v_cvt_pk_bf16_f32 v120, v104, v105
    ds_write_b32 v3, v120 offset:384
    ds_read_b128 v[104:107], v6 offset:384
    ds_read_b128 v[108:111], v6 offset:400
    v_and_b32 v112, 16, v0
    v_cmp_ne_u32 vcc, 0, v112
    s_waitcnt lgkmcnt(1)
    v_mfma_f32_16x16x32_bf16 v[48:51], v[104:107], v[80:83], 0
    v_mfma_f32_16x16x32_bf16 v[64:67], v[104:107], v[8:11], 0
    v_mfma_f32_16x16x32_bf16 v[52:55], v[104:107], v[84:87], 0
    v_mfma_f32_16x16x32_bf16 v[68:71], v[104:107], v[12:15], 0
    v_mfma_f32_16x16x32_bf16 v[56:59], v[104:107], v[88:91], 0
    v_mfma_f32_16x16x32_bf16 v[72:75], v[104:107], v[136:139], 0
    v_mfma_f32_16x16x32_bf16 v[60:63], v[104:107], v[92:95], 0
    v_mfma_f32_16x16x32_bf16 v[76:79], v[104:107], v[140:143], 0
    s_waitcnt lgkmcnt(0)
    v_mfma_f32_16x16x32_bf16 v[48:51], v[108:111], v[16:19], v[48:51]
    v_mfma_f32_16x16x32_bf16 v[64:67], v[108:111], v[32:35], v[64:67]
    v_mfma_f32_16x16x32_bf16 v[52:55], v[108:111], v[20:23], v[52:55]
    v_mfma_f32_16x16x32_bf16 v[68:71], v[108:111], v[36:39], v[68:71]
    v_mfma_f32_16x16x32_bf16 v[56:59], v[108:111], v[24:27], v[56:59]
    v_mfma_f32_16x16x32_bf16 v[72:75], v[108:111], v[40:43], v[72:75]
    v_mfma_f32_16x16x32_bf16 v[60:63], v[108:111], v[28:31], v[60:63]
    v_mfma_f32_16x16x32_bf16 v[76:79], v[108:111], v[44:47], v[76:79]
    s_nop 1
    v_cndmask_b32 v96, v48, v64, vcc
    v_bfi_b32 v96, v7, s52, v96
    v_cndmask_b32 v97, v52, v68, vcc
    v_bfi_b32 v97, v7, s98, v97
    v_cndmask_b32 v98, v56, v72, vcc
    v_bfi_b32 v98, v7, s99, v98
    v_cndmask_b32 v99, v60, v76, vcc
    v_bfi_b32 v99, v7, s100, v99
    buffer_store_dwordx4 v[96:99], v2, s[36:39], s51 offen sc1
    s_branch L_ystored
L_fsetup:
    s_mov_b32 s34, 1409024
    s_cmp_lt_u32 s2, 176
    s_cbranch_scc0 L_fsetup2
    s_movk_i32 s49, 2752
    s_bfe_u32 s42, s2, 0x30001
    s_lshl_b32 s54, s42, 6
    s_mul_i32 s50, s54, 2752
    s_lshr_b32 s43, s2, 4
    s_cmp_eq_u32 s43, 10
    s_cselect_b32 s57, 12, 16
    s_lshl_b32 s44, s43, 8
    s_add_u32 s50, s50, s44
    s_and_b32 s44, s2, 1
    s_lshl_b32 s44, s44, 3
    s_add_u32 s44, s44, s42
    s_mul_i32 s51, s44, 11264
    s_lshl_b32 s44, s43, 9
    s_add_u32 s51, s51, s44
    s_add_u32 s51, s51, 393216
    s_movk_i32 s55, 5632
    s_waitcnt lgkmcnt(0)
    s_bitcmp1_b32 s2, 0
    s_cselect_b32 s32, s18, s16
    s_cselect_b32 s33, s19, s17
    s_branch L_wcommon
L_fsetup2:
    s_mov_b32 s48, 2
    s_movk_i32 s49, 1024
    s_movk_i32 s55, 512
    s_sub_u32 s42, s2, 176
    s_lshr_b32 s42, s42, 2
    s_lshl_b32 s54, s42, 6
    s_and_b32 s43, s2, 3
    s_lshl_b32 s50, s54, 10
    s_lshl_b32 s44, s43, 8
    s_add_u32 s50, s50, s44
    s_mul_i32 s51, s43, 24
    s_add_u32 s51, s51, s42
    s_lshl_b32 s51, s51, 10
    s_add_u32 s51, s51, 1179648
    s_waitcnt lgkmcnt(0)
    s_mov_b32 s32, s20
    s_mov_b32 s33, s21
    s_branch L_wcommon
L_fpost:
    s_cmp_lg_u32 s48, 0
    s_cbranch_scc1 L_end
    s_cmp_lt_u32 s2, 160
    s_cbranch_scc1 L_end
    s_bfe_u32 s42, s2, 0x20002
    s_mul_i32 s54, s42, 24
    s_add_u32 s54, s54, 1280
    s_add_u32 s42, s42, 20
    s_add_u32 s34, s54, 24
    s_lshl_b32 s34, s34, 10
    s_and_b32 s43, s2, 3
    s_lshl_b32 s50, s54, 10
    s_lshl_b32 s44, s43, 8
    s_add_u32 s50, s50, s44
    s_mul_i32 s51, s43, 24
    s_add_u32 s51, s51, s42
    s_lshl_b32 s51, s51, 10
    s_add_u32 s51, s51, 1179648
    s_mov_b32 s32, s20
    s_mov_b32 s33, s21
    s_branch L_toph1
L_fphase1:
    v_lshrrev_b32 v100, 5, v0
    v_and_b32 v101, 31, v0
    s_lshl_b32 s42, s54, 2
    v_mul_u32_u24 v100, 5632, v100
    v_lshl_add_u32 v101, v101, 3, s42
    v_min_u32 v101, 5624, v101
    v_add_u32 v100, v100, v101
    v_and_b32 v101, 8, v101
    v_cmp_eq_u32 vcc, 0, v101
    v_mov_b32 v128, s52
    v_mov_b32 v129, s99
    v_cndmask_b32 v128, v129, v128, vcc
    v_mov_b32 v129, s98
    v_mov_b32 v101, s100
    v_cndmask_b32 v129, v101, v129, vcc
    s_mov_b32 s42, 393216
    s_mov_b32 s53, 2097152
L_hspin:
    ds_read_b32 v101, v124 offset:256
    s_waitcnt lgkmcnt(0)
    v_readfirstlane_b32 s57, v101
    s_sub_u32 s53, s53, 1
    s_cbranch_scc1 L_hspin_done
    s_cmp_lg_u32 s57, 1
    s_cbranch_scc1 L_hspin
L_hspin_done:
    s_mov_b32 s53, 262144
L_hpoll:
    s_mov_b32 s43, s42
    buffer_load_dwordx2 v[80:81], v100, s[36:39], s43 offen sc1
    s_add_u32 s43, s43, 11264
    buffer_load_dwordx2 v[82:83], v100, s[36:39], s43 offen sc1
    s_add_u32 s43, s43, 11264
    buffer_load_dwordx2 v[84:85], v100, s[36:39], s43 offen sc1
    s_add_u32 s43, s43, 11264
    buffer_load_dwordx2 v[86:87], v100, s[36:39], s43 offen sc1
    s_add_u32 s43, s43, 11264
    buffer_load_dwordx2 v[88:89], v100, s[36:39], s43 offen sc1
    s_add_u32 s43, s43, 11264
    buffer_load_dwordx2 v[90:91], v100, s[36:39], s43 offen sc1
    s_add_u32 s43, s43, 11264
    buffer_load_dwordx2 v[92:93], v100, s[36:39], s43 offen sc1
    s_add_u32 s43, s43, 11264
    buffer_load_dwordx2 v[94:95], v100, s[36:39], s43 offen sc1
    s_add_u32 s43, s43, 11264
    buffer_load_dwordx2 v[104:105], v100, s[36:39], s43 offen sc1
    s_add_u32 s43, s43, 11264
    buffer_load_dwordx2 v[106:107], v100, s[36:39], s43 offen sc1
    s_add_u32 s43, s43, 11264
    buffer_load_dwordx2 v[108:109], v100, s[36:39], s43 offen sc1
    s_add_u32 s43, s43, 11264
    buffer_load_dwordx2 v[110:111], v100, s[36:39], s43 offen sc1
    s_add_u32 s43, s43, 11264
    buffer_load_dwordx2 v[112:113], v100, s[36:39], s43 offen sc1
    s_add_u32 s43, s43, 11264
    buffer_load_dwordx2 v[114:115], v100, s[36:39], s43 offen sc1
    s_add_u32 s43, s43, 11264
    buffer_load_dwordx2 v[116:117], v100, s[36:39], s43 offen sc1
    s_add_u32 s43, s43, 11264
    buffer_load_dwordx2 v[118:119], v100, s[36:39], s43 offen sc1
    s_waitcnt vmcnt(0)
    v_xor_b32 v126, v128, v80
    v_bitop3_b32 v126, v81, v129, v126 bitop3:0xbe
    v_bitop3_b32 v126, v82, v128, v126 bitop3:0xbe
    v_bitop3_b32 v126, v83, v129, v126 bitop3:0xbe
    v_bitop3_b32 v126, v84, v128, v126 bitop3:0xbe
    v_bitop3_b32 v126, v85, v129, v126 bitop3:0xbe
    v_bitop3_b32 v126, v86, v128, v126 bitop3:0xbe
    v_bitop3_b32 v126, v87, v129, v126 bitop3:0xbe
    v_bitop3_b32 v126, v88, v128, v126 bitop3:0xbe
    v_bitop3_b32 v126, v89, v129, v126 bitop3:0xbe
    v_bitop3_b32 v126, v90, v128, v126 bitop3:0xbe
    v_bitop3_b32 v126, v91, v129, v126 bitop3:0xbe
    v_bitop3_b32 v126, v92, v128, v126 bitop3:0xbe
    v_bitop3_b32 v126, v93, v129, v126 bitop3:0xbe
    v_bitop3_b32 v126, v94, v128, v126 bitop3:0xbe
    v_bitop3_b32 v126, v95, v129, v126 bitop3:0xbe
    v_bitop3_b32 v126, v104, v128, v126 bitop3:0xbe
    v_bitop3_b32 v126, v105, v129, v126 bitop3:0xbe
    v_bitop3_b32 v126, v106, v128, v126 bitop3:0xbe
    v_bitop3_b32 v126, v107, v129, v126 bitop3:0xbe
    v_bitop3_b32 v126, v108, v128, v126 bitop3:0xbe
    v_bitop3_b32 v126, v109, v129, v126 bitop3:0xbe
    v_bitop3_b32 v126, v110, v128, v126 bitop3:0xbe
    v_bitop3_b32 v126, v111, v129, v126 bitop3:0xbe
    v_bitop3_b32 v126, v112, v128, v126 bitop3:0xbe
    v_bitop3_b32 v126, v113, v129, v126 bitop3:0xbe
    v_bitop3_b32 v126, v114, v128, v126 bitop3:0xbe
    v_bitop3_b32 v126, v115, v129, v126 bitop3:0xbe
    v_bitop3_b32 v126, v116, v128, v126 bitop3:0xbe
    v_bitop3_b32 v126, v117, v129, v126 bitop3:0xbe
    v_bitop3_b32 v126, v118, v128, v126 bitop3:0xbe
    v_bitop3_b32 v126, v119, v129, v126 bitop3:0xbe
    v_and_b32 v126, v7, v126
    v_cmp_ne_u32 vcc, 0, v126
    s_cbranch_vccz L_hpoll_done
    s_sub_u32 s53, s53, 1
    s_cbranch_scc0 L_hpoll
L_hpoll_done:
    v_pk_add_f32 v[80:81], v[80:81], v[82:83]
    v_pk_add_f32 v[84:85], v[84:85], v[86:87]
    v_pk_add_f32 v[88:89], v[88:89], v[90:91]
    v_pk_add_f32 v[92:93], v[92:93], v[94:95]
    v_pk_add_f32 v[80:81], v[80:81], v[84:85]
    v_pk_add_f32 v[88:89], v[88:89], v[92:93]
    v_pk_add_f32 v[80:81], v[80:81], v[88:89]
    v_pk_add_f32 v[104:105], v[104:105], v[106:107]
    v_pk_add_f32 v[108:109], v[108:109], v[110:111]
    v_pk_add_f32 v[112:113], v[112:113], v[114:115]
    v_pk_add_f32 v[116:117], v[116:117], v[118:119]
    v_pk_add_f32 v[104:105], v[104:105], v[108:109]
    v_pk_add_f32 v[112:113], v[112:113], v[116:117]
    v_pk_add_f32 v[104:105], v[104:105], v[112:113]
    v_cvt_pk_bf16_f32 v80, v80, v81
    v_cvt_pk_bf16_f32 v104, v104, v105
    v_and_b32 v81, s45, v80
    v_lshlrev_b32 v80, 16, v80
    v_and_b32 v105, s45, v104
    v_lshlrev_b32 v104, 16, v104
    v_mul_f32 v80, s46, v80
    v_mul_f32 v81, s46, v81
    v_exp_f32 v80, -v80
    v_exp_f32 v81, -v81
    v_add_f32 v80, 1.0, v80
    v_add_f32 v81, 1.0, v81
    v_rcp_f32 v80, v80
    v_rcp_f32 v81, v81
    s_nop 0
    v_cvt_pk_bf16_f32 v80, v80, v81
    v_and_b32 v81, s45, v80
    v_lshlrev_b32 v80, 16, v80
    v_mul_f32 v80, v80, v104
    v_mul_f32 v81, v81, v105
    v_cvt_pk_bf16_f32 v120, v80, v81
    s_branch L_core
L_kvrole:
    s_lshr_b32 s42, s41, 2
    s_lshl_b32 s42, s42, 25
    s_lshl_b32 s43, s40, 20
    s_add_u32 s42, s42, s43
    s_and_b32 s43, s41, 3
    s_lshl_b32 s43, s43, 16
    s_add_u32 s42, s42, s43
    s_sub_u32 s3, s3, 2
    s_lshl_b32 s43, s3, 13
    s_add_u32 s42, s42, s43
    s_add_u32 s42, s42, 0xC0000
    s_add_u32 s43, s42, 4096
    v_lshlrev_b32 v1, 4, v0
    v_mov_b32 v88, 0
    v_mov_b32 v89, 1
    s_mov_b32 s30, 0x4000000
    s_mov_b32 s31, 0x20000
    s_mov_b32 s34, 0x4000000
    s_mov_b32 s35, 0x20000
    s_waitcnt lgkmcnt(0)
    s_mov_b32 s28, s6
    s_mov_b32 s29, s7
    s_mov_b32 s32, s8
    s_mov_b32 s33, s9
    s_barrier
    buffer_load_dwordx4 v[16:19], v1, s[28:31], s42 offen offset:0 nt
    buffer_load_dwordx4 v[20:23], v1, s[28:31], s42 offen offset:1024 nt
    buffer_load_dwordx4 v[24:27], v1, s[28:31], s42 offen offset:2048 nt
    v_and_b32 v2, 1, v0
    v_cmp_eq_u32 vcc, 1, v2
    v_mov_b32 v3, 0x0c0c0100
    v_mov_b32 v4, 0x01000c0c
    v_cndmask_b32 v3, v3, v4, vcc
    v_mov_b32 v4, 0x0c0c0302
    v_mov_b32 v5, 0x03020c0c
    v_cndmask_b32 v4, v4, v5, vcc
    v_bfe_u32 v2, v0, 1, 2
    v_mov_b32 v5, 0x0c0c0c0c
    v_cmp_eq_u32 vcc, 0, v2
    s_nop 1
    v_cndmask_b32 v8, v5, v3, vcc
    v_cndmask_b32 v12, v5, v4, vcc
    v_cmp_eq_u32 vcc, 1, v2
    s_nop 1
    v_cndmask_b32 v9, v5, v3, vcc
    v_cndmask_b32 v13, v5, v4, vcc
    v_cmp_eq_u32 vcc, 2, v2
    s_nop 1
    v_cndmask_b32 v10, v5, v3, vcc
    v_cndmask_b32 v14, v5, v4, vcc
    v_cmp_eq_u32 vcc, 3, v2
    s_nop 1
    v_cndmask_b32 v11, v5, v3, vcc
    v_cndmask_b32 v15, v5, v4, vcc
    s_mov_b32 s44, 0x3db504f3
    s_mov_b32 s45, 0xffff0000
    s_mov_b32 s46, 0x3fb8aa3b
    v_and_b32 v2, 15, v0
    v_lshlrev_b32 v90, 4, v2
    v_lshlrev_b32 v2, 5, v2
    v_and_b32 v4, 16, v0
    v_add_u32 v2, v2, v4
    s_lshl_b32 s47, s3, 9
    v_add_u32 v2, s47, v2
    s_lshl_b32 s47, s3, 2
    v_mov_b32 v3, s47
    s_waitcnt vmcnt(2)
    buffer_load_dwordx4 v[28:31], v1, s[28:31], s42 offen offset:3072 nt
    s_waitcnt vmcnt(2)
    buffer_load_dwordx4 v[32:35], v1, s[28:31], s43 offen offset:0 nt
    ds_read_b32 v91, v88 offset:256
    s_waitcnt lgkmcnt(0)
    v_readfirstlane_b32 s57, v91
    s_cmp_lg_u32 s57, 0
    s_cbranch_scc1 L_burst5
    s_waitcnt vmcnt(2)
    buffer_load_dwordx4 v[36:39], v1, s[28:31], s43 offen offset:1024 nt
    ds_read_b32 v91, v88 offset:256
    s_waitcnt lgkmcnt(0)
    v_readfirstlane_b32 s57, v91
    s_cmp_lg_u32 s57, 0
    s_cbranch_scc1 L_burst6
    s_waitcnt vmcnt(2)
    buffer_load_dwordx4 v[40:43], v1, s[28:31], s43 offen offset:2048 nt
    ds_read_b32 v91, v88 offset:256
    s_waitcnt lgkmcnt(0)
    v_readfirstlane_b32 s57, v91
    s_cmp_lg_u32 s57, 0
    s_cbranch_scc1 L_burst7
    s_waitcnt vmcnt(2)
    buffer_load_dwordx4 v[44:47], v1, s[28:31], s43 offen offset:3072 nt
    ds_read_b32 v91, v88 offset:256
    s_waitcnt lgkmcnt(0)
    v_readfirstlane_b32 s57, v91
    s_cmp_lg_u32 s57, 0
    s_cbranch_scc1 L_burst8
    s_waitcnt vmcnt(2)
    buffer_load_dwordx4 v[48:51], v1, s[32:35], s42 offen offset:0 nt
    ds_read_b32 v91, v88 offset:256
    s_waitcnt lgkmcnt(0)
    v_readfirstlane_b32 s57, v91
    s_cmp_lg_u32 s57, 0
    s_cbranch_scc1 L_burst9
    s_waitcnt vmcnt(2)
    buffer_load_dwordx4 v[52:55], v1, s[32:35], s42 offen offset:1024 nt
    ds_read_b32 v91, v88 offset:256
    s_waitcnt lgkmcnt(0)
    v_readfirstlane_b32 s57, v91
    s_cmp_lg_u32 s57, 0
    s_cbranch_scc1 L_burst10
    s_waitcnt vmcnt(2)
    buffer_load_dwordx4 v[56:59], v1, s[32:35], s42 offen offset:2048 nt
    ds_read_b32 v91, v88 offset:256
    s_waitcnt lgkmcnt(0)
    v_readfirstlane_b32 s57, v91
    s_cmp_lg_u32 s57, 0
    s_cbranch_scc1 L_burst11
    s_waitcnt vmcnt(2)
    buffer_load_dwordx4 v[60:63], v1, s[32:35], s42 offen offset:3072 nt
    ds_read_b32 v91, v88 offset:256
    s_waitcnt lgkmcnt(0)
    v_readfirstlane_b32 s57, v91
    s_cmp_lg_u32 s57, 0
    s_cbranch_scc1 L_burst12
    s_waitcnt vmcnt(2)
    buffer_load_dwordx4 v[64:67], v1, s[32:35], s43 offen offset:0 nt
    ds_read_b32 v91, v88 offset:256
    s_waitcnt lgkmcnt(0)
    v_readfirstlane_b32 s57, v91
    s_cmp_lg_u32 s57, 0
    s_cbranch_scc1 L_burst13
    s_waitcnt vmcnt(2)
    buffer_load_dwordx4 v[68:71], v1, s[32:35], s43 offen offset:1024 nt
    ds_read_b32 v91, v88 offset:256
    s_waitcnt lgkmcnt(0)
    v_readfirstlane_b32 s57, v91
    s_cmp_lg_u32 s57, 0
    s_cbranch_scc1 L_burst14
    s_waitcnt vmcnt(2)
    buffer_load_dwordx4 v[72:75], v1, s[32:35], s43 offen offset:2048 nt
    ds_read_b32 v91, v88 offset:256
    s_waitcnt lgkmcnt(0)
    v_readfirstlane_b32 s57, v91
    s_cmp_lg_u32 s57, 0
    s_cbranch_scc1 L_burst15
    s_waitcnt vmcnt(2)
    buffer_load_dwordx4 v[76:79], v1, s[32:35], s43 offen offset:3072 nt
    s_mov_b64 exec, 1
    ds_add_u32 v88, v89 offset:260
    s_mov_b64 exec, -1
    s_mov_b32 s53, 2097152
L_qspin:
    ds_read_b32 v91, v88 offset:256
    s_waitcnt lgkmcnt(0)
    v_readfirstlane_b32 s57, v91
    s_sub_u32 s53, s53, 1
    s_cbranch_scc1 L_qspin_done
    s_cmp_lg_u32 s57, 1
    s_cbranch_scc1 L_qspin
L_qspin_done:
    s_branch L_qk
L_burst5:
    buffer_load_dwordx4 v[36:39], v1, s[28:31], s43 offen offset:1024 nt
L_burst6:
    buffer_load_dwordx4 v[40:43], v1, s[28:31], s43 offen offset:2048 nt
L_burst7:
    buffer_load_dwordx4 v[44:47], v1, s[28:31], s43 offen offset:3072 nt
L_burst8:
    buffer_load_dwordx4 v[48:51], v1, s[32:35], s42 offen offset:0 nt
L_burst9:
    buffer_load_dwordx4 v[52:55], v1, s[32:35], s42 offen offset:1024 nt
L_burst10:
    buffer_load_dwordx4 v[56:59], v1, s[32:35], s42 offen offset:2048 nt
L_burst11:
    buffer_load_dwordx4 v[60:63], v1, s[32:35], s42 offen offset:3072 nt
L_burst12:
    buffer_load_dwordx4 v[64:67], v1, s[32:35], s43 offen offset:0 nt
L_burst13:
    buffer_load_dwordx4 v[68:71], v1, s[32:35], s43 offen offset:1024 nt
L_burst14:
    buffer_load_dwordx4 v[72:75], v1, s[32:35], s43 offen offset:2048 nt
L_burst15:
    buffer_load_dwordx4 v[76:79], v1, s[32:35], s43 offen offset:3072 nt
    s_mov_b64 exec, 1
    ds_add_u32 v88, v89 offset:260
    s_mov_b64 exec, -1
L_qk:
    ds_read_b128 v[4:7], v90 offset:0
    v_mov_b32 v80, 0
    v_mov_b32 v81, 0
    v_mov_b32 v82, 0
    v_mov_b32 v83, 0
    v_mov_b32 v84, 0
    v_mov_b32 v85, 0
    v_mov_b32 v86, 0
    v_mov_b32 v87, 0
    s_waitcnt lgkmcnt(0)
    s_waitcnt vmcnt(15)
    v_dot2c_f32_bf16 v80, v16, v4
    v_dot2c_f32_bf16 v80, v17, v5
    v_dot2c_f32_bf16 v80, v18, v6
    v_dot2c_f32_bf16 v80, v19, v7
    s_waitcnt vmcnt(14)
    v_dot2c_f32_bf16 v81, v20, v4
    v_dot2c_f32_bf16 v81, v21, v5
    v_dot2c_f32_bf16 v81, v22, v6
    v_dot2c_f32_bf16 v81, v23, v7
    s_waitcnt vmcnt(13)
    v_dot2c_f32_bf16 v82, v24, v4
    v_dot2c_f32_bf16 v82, v25, v5
    v_dot2c_f32_bf16 v82, v26, v6
    v_dot2c_f32_bf16 v82, v27, v7
    s_waitcnt vmcnt(12)
    v_dot2c_f32_bf16 v83, v28, v4
    v_dot2c_f32_bf16 v83, v29, v5
    v_dot2c_f32_bf16 v83, v30, v6
    v_dot2c_f32_bf16 v83, v31, v7
    s_waitcnt vmcnt(11)
    v_dot2c_f32_bf16 v84, v32, v4
    v_dot2c_f32_bf16 v84, v33, v5
    v_dot2c_f32_bf16 v84, v34, v6
    v_dot2c_f32_bf16 v84, v35, v7
    s_waitcnt vmcnt(10)
    v_dot2c_f32_bf16 v85, v36, v4
    v_dot2c_f32_bf16 v85, v37, v5
    v_dot2c_f32_bf16 v85, v38, v6
    v_dot2c_f32_bf16 v85, v39, v7
    s_waitcnt vmcnt(9)
    v_dot2c_f32_bf16 v86, v40, v4
    v_dot2c_f32_bf16 v86, v41, v5
    v_dot2c_f32_bf16 v86, v42, v6
    v_dot2c_f32_bf16 v86, v43, v7
    s_waitcnt vmcnt(8)
    v_dot2c_f32_bf16 v87, v44, v4
    v_dot2c_f32_bf16 v87, v45, v5
    v_dot2c_f32_bf16 v87, v46, v6
    v_dot2c_f32_bf16 v87, v47, v7
    v_add_f32_dpp v80, v80, v80 row_ror:8 row_mask:0xf bank_mask:0xf
    v_add_f32_dpp v81, v81, v81 row_ror:8 row_mask:0xf bank_mask:0xf
    v_add_f32_dpp v82, v82, v82 row_ror:8 row_mask:0xf bank_mask:0xf
    v_add_f32_dpp v83, v83, v83 row_ror:8 row_mask:0xf bank_mask:0xf
    v_add_f32_dpp v84, v84, v84 row_ror:8 row_mask:0xf bank_mask:0xf
    v_add_f32_dpp v85, v85, v85 row_ror:8 row_mask:0xf bank_mask:0xf
    v_add_f32_dpp v86, v86, v86 row_ror:8 row_mask:0xf bank_mask:0xf
    v_add_f32_dpp v87, v87, v87 row_ror:8 row_mask:0xf bank_mask:0xf
    v_add_f32_dpp v80, v80, v80 row_ror:4 row_mask:0xf bank_mask:0xf
    v_add_f32_dpp v81, v81, v81 row_ror:4 row_mask:0xf bank_mask:0xf
    v_add_f32_dpp v82, v82, v82 row_ror:4 row_mask:0xf bank_mask:0xf
    v_add_f32_dpp v83, v83, v83 row_ror:4 row_mask:0xf bank_mask:0xf
    v_add_f32_dpp v84, v84, v84 row_ror:4 row_mask:0xf bank_mask:0xf
    v_add_f32_dpp v85, v85, v85 row_ror:4 row_mask:0xf bank_mask:0xf
    v_add_f32_dpp v86, v86, v86 row_ror:4 row_mask:0xf bank_mask:0xf
    v_add_f32_dpp v87, v87, v87 row_ror:4 row_mask:0xf bank_mask:0xf
    v_add_f32_dpp v80, v80, v80 row_ror:2 row_mask:0xf bank_mask:0xf
    v_add_f32_dpp v81, v81, v81 row_ror:2 row_mask:0xf bank_mask:0xf
    v_add_f32_dpp v82, v82, v82 row_ror:2 row_mask:0xf bank_mask:0xf
    v_add_f32_dpp v83, v83, v83 row_ror:2 row_mask:0xf bank_mask:0xf
    v_add_f32_dpp v84, v84, v84 row_ror:2 row_mask:0xf bank_mask:0xf
    v_add_f32_dpp v85, v85, v85 row_ror:2 row_mask:0xf bank_mask:0xf
    v_add_f32_dpp v86, v86, v86 row_ror:2 row_mask:0xf bank_mask:0xf
    v_add_f32_dpp v87, v87, v87 row_ror:2 row_mask:0xf bank_mask:0xf
    v_add_f32_dpp v80, v80, v80 row_ror:1 row_mask:0xf bank_mask:0xf
    v_add_f32_dpp v81, v81, v81 row_ror:1 row_mask:0xf bank_mask:0xf
    v_add_f32_dpp v82, v82, v82 row_ror:1 row_mask:0xf bank_mask:0xf
    v_add_f32_dpp v83, v83, v83 row_ror:1 row_mask:0xf bank_mask:0xf
    v_add_f32_dpp v84, v84, v84 row_ror:1 row_mask:0xf bank_mask:0xf
    v_add_f32_dpp v85, v85, v85 row_ror:1 row_mask:0xf bank_mask:0xf
    v_add_f32_dpp v86, v86, v86 row_ror:1 row_mask:0xf bank_mask:0xf
    v_add_f32_dpp v87, v87, v87 row_ror:1 row_mask:0xf bank_mask:0xf
    v_cvt_pk_bf16_f32 v16, v80, v81
    v_cvt_pk_bf16_f32 v17, v82, v83
    v_cvt_pk_bf16_f32 v18, v84, v85
    v_cvt_pk_bf16_f32 v19, v86, v87
    v_lshlrev_b32 v80, 16, v16
    v_and_b32 v81, s45, v16
    v_lshlrev_b32 v82, 16, v17
    v_and_b32 v83, s45, v17
    v_lshlrev_b32 v84, 16, v18
    v_and_b32 v85, s45, v18
    v_lshlrev_b32 v86, 16, v19
    v_and_b32 v87, s45, v19
    v_mul_f32 v80, s44, v80
    v_mul_f32 v81, s44, v81
    v_mul_f32 v82, s44, v82
    v_mul_f32 v83, s44, v83
    v_mul_f32 v84, s44, v84
    v_mul_f32 v85, s44, v85
    v_mul_f32 v86, s44, v86
    v_mul_f32 v87, s44, v87
    v_cvt_pk_bf16_f32 v16, v80, v81
    v_cvt_pk_bf16_f32 v17, v82, v83
    v_cvt_pk_bf16_f32 v18, v84, v85
    v_cvt_pk_bf16_f32 v19, v86, v87
    v_lshlrev_b32 v80, 16, v16
    v_and_b32 v81, s45, v16
    v_lshlrev_b32 v82, 16, v17
    v_and_b32 v83, s45, v17
    v_lshlrev_b32 v84, 16, v18
    v_and_b32 v85, s45, v18
    v_lshlrev_b32 v86, 16, v19
    v_and_b32 v87, s45, v19
    v_max3_f32 v16, v80, v81, v82
    v_max3_f32 v17, v83, v84, v85
    v_max3_f32 v16, v16, v86, v87
    v_max_f32 v16, v16, v17
    v_mov_b32 v17, v16
    s_nop 1
    v_permlane16_swap_b32 v16, v17
    v_max_f32 v16, v16, v17
    v_mov_b32 v17, v16
    s_nop 1
    v_permlane32_swap_b32 v16, v17
    v_max_f32 v16, v16, v17
    ds_write_b32 v3, v16 offset:288
    v_sub_f32 v80, v80, v16
    v_sub_f32 v81, v81, v16
    v_sub_f32 v82, v82, v16
    v_sub_f32 v83, v83, v16
    v_sub_f32 v84, v84, v16
    v_sub_f32 v85, v85, v16
    v_sub_f32 v86, v86, v16
    v_sub_f32 v87, v87, v16
    v_mul_f32 v80, s46, v80
    v_mul_f32 v81, s46, v81
    v_mul_f32 v82, s46, v82
    v_mul_f32 v83, s46, v83
    v_mul_f32 v84, s46, v84
    v_mul_f32 v85, s46, v85
    v_mul_f32 v86, s46, v86
    v_mul_f32 v87, s46, v87
    v_exp_f32 v80, v80
    v_exp_f32 v81, v81
    v_exp_f32 v82, v82
    v_exp_f32 v83, v83
    v_exp_f32 v84, v84
    v_exp_f32 v85, v85
    v_exp_f32 v86, v86
    v_exp_f32 v87, v87
    v_cvt_pk_bf16_f32 v4, v80, v81
    v_cvt_pk_bf16_f32 v5, v82, v83
    v_cvt_pk_bf16_f32 v6, v84, v85
    v_cvt_pk_bf16_f32 v7, v86, v87
    v_add_f32 v80, v80, v81
    v_add_f32 v82, v82, v83
    v_add_f32 v84, v84, v85
    v_add_f32 v86, v86, v87
    v_add_f32 v80, v80, v82
    v_add_f32 v84, v84, v86
    v_add_f32 v80, v80, v84
    v_mov_b32 v81, v80
    s_nop 1
    v_permlane16_swap_b32 v80, v81
    v_add_f32 v80, v80, v81
    v_mov_b32 v81, v80
    s_nop 1
    v_permlane32_swap_b32 v80, v81
    v_add_f32 v80, v80, v81
    s_mov_b64 exec, 1
    ds_write_b32 v3, v80 offset:320
    ds_add_u32 v88, v89 offset:264
    s_mov_b64 exec, -1
    v_mov_b32 v84, 0
    v_mov_b32 v85, 0
    v_mov_b32 v86, 0
    v_mov_b32 v87, 0
    v_perm_b32 v16, v4, v4, v8
    v_perm_b32 v17, v4, v4, v9
    v_perm_b32 v18, v4, v4, v10
    v_perm_b32 v19, v4, v4, v11
    v_perm_b32 v20, v4, v4, v12
    v_perm_b32 v21, v4, v4, v13
    v_perm_b32 v22, v4, v4, v14
    v_perm_b32 v23, v4, v4, v15
    v_perm_b32 v24, v5, v5, v8
    v_perm_b32 v25, v5, v5, v9
    v_perm_b32 v26, v5, v5, v10
    v_perm_b32 v27, v5, v5, v11
    v_perm_b32 v28, v5, v5, v12
    v_perm_b32 v29, v5, v5, v13
    v_perm_b32 v30, v5, v5, v14
    v_perm_b32 v31, v5, v5, v15
    v_perm_b32 v32, v6, v6, v8
    v_perm_b32 v33, v6, v6, v9
    v_perm_b32 v34, v6, v6, v10
    v_perm_b32 v35, v6, v6, v11
    v_perm_b32 v36, v6, v6, v12
    v_perm_b32 v37, v6, v6, v13
    v_perm_b32 v38, v6, v6, v14
    v_perm_b32 v39, v6, v6, v15
    v_perm_b32 v40, v7, v7, v8
    v_perm_b32 v41, v7, v7, v9
    v_perm_b32 v42, v7, v7, v10
    v_perm_b32 v43, v7, v7, v11
    v_perm_b32 v44, v7, v7, v12
    v_perm_b32 v45, v7, v7, v13
    v_perm_b32 v46, v7, v7, v14
    v_perm_b32 v47, v7, v7, v15
    s_waitcnt vmcnt(7)
    v_mfma_f32_16x16x32_bf16 v[84:87], v[16:19], v[48:51], v[84:87]
    s_waitcnt vmcnt(6)
    v_mfma_f32_16x16x32_bf16 v[84:87], v[20:23], v[52:55], v[84:87]
    s_waitcnt vmcnt(5)
    v_mfma_f32_16x16x32_bf16 v[84:87], v[24:27], v[56:59], v[84:87]
    s_waitcnt vmcnt(4)
    v_mfma_f32_16x16x32_bf16 v[84:87], v[28:31], v[60:63], v[84:87]
    s_waitcnt vmcnt(3)
    v_mfma_f32_16x16x32_bf16 v[84:87], v[32:35], v[64:67], v[84:87]
    s_waitcnt vmcnt(2)
    v_mfma_f32_16x16x32_bf16 v[84:87], v[36:39], v[68:71], v[84:87]
    s_waitcnt vmcnt(1)
    v_mfma_f32_16x16x32_bf16 v[84:87], v[40:43], v[72:75], v[84:87]
    s_waitcnt vmcnt(0)
    v_mfma_f32_16x16x32_bf16 v[84:87], v[44:47], v[76:79], v[84:87]
    s_mov_b32 exec_hi, 0
    s_nop 6
    ds_write_b128 v2, v[84:87] offset:1024
    s_mov_b32 exec_lo, 1
    ds_add_u32 v88, v89 offset:268
    s_endpgm
.section .rodata,"a"
.p2align 6
.amdhsa_kernel parallel_sum__sliding_block_cached__glu_gated_glu__decode_kernel
  .amdhsa_next_free_vgpr 144
  .amdhsa_next_free_sgpr 102
  .amdhsa_accum_offset 144
  .amdhsa_group_segment_fixed_size 0
  .amdhsa_kernarg_size 96
  .amdhsa_user_sgpr_count 2
  .amdhsa_user_sgpr_kernarg_segment_ptr 1
  .amdhsa_system_sgpr_workgroup_id_x 1
.end_amdhsa_kernel
```
